```python
import torch

def _softmax(x, axis=-1):
    return torch.softmax(x, dim=axis)
def _gelu(x):
    return torch.nn.functional.gelu(x, approximate="tanh")
def _silu(x):
    return torch.nn.functional.silu(x)
def _sigmoid(x):
    return torch.sigmoid(x)
def _layernorm(x, axis=-1, eps=1e-5):
    m = x.mean(dim=axis, keepdim=True)
    v = x.var(dim=axis, keepdim=True, unbiased=False)
    return (x - m) / torch.sqrt(v + eps)
def _scatter_add(tgt, idx, src, axis=0):
    return tgt.clone().index_add_(axis, idx, src)
def _segment_sum(src, seg, n):
    out = torch.zeros((n,) + src.shape[1:], dtype=src.dtype)
    return out.index_add_(0, seg, src)
def _pad(x, pw):
    flat = tuple(v for pair in reversed(pw) for v in pair)
    return torch.nn.functional.pad(x, flat)

kernel_name = 'sequential_preLN__gqa_block_cached__swiglu_ffn__decode'

def setup_inputs():

    _w = (lambda a: (lambda t: t.to(torch.bfloat16) if t.is_floating_point() else t)(torch.as_tensor(a)))
    def _A_setup():
        B, Sq, D = 2, 1, 512
        Hq, Hkv, Sk, Dh = 32, 8, 32768, 128
        assert Hq % Hkv == 0, (Hq, Hkv)
        return {
            "x": _w((lambda *s: torch.randn(*s, dtype=torch.bfloat16) * 0.05)(B, Sq, D)),
            "k_cache": _w((lambda *s: torch.randn(*s, dtype=torch.bfloat16) * 3.2)(B, Hkv, Sk, Dh)),
            "v_cache": _w((lambda *s: torch.randn(*s, dtype=torch.bfloat16) * 0.4)(B, Hkv, Sk, Dh)),
            "wq": _w((lambda *s: torch.randn(*s, dtype=torch.bfloat16) * 3.2)(D, Hq * Dh) * (D ** -0.5)),
            "wo": _w((lambda *s: torch.randn(*s, dtype=torch.bfloat16) * 0.4)(Hq * Dh, D) * ((Hq * Dh) ** -0.5)),
        }
    _A_in = _A_setup()

    def _B_setup():
        B, S, D, F = 2, 1, 512, 1792
        return {
            "x": _w((lambda *s: torch.randn(*s, dtype=torch.bfloat16) * 0.05)(B, S, D)),
            "w_gate": _w((lambda *s: torch.randn(*s, dtype=torch.bfloat16) * 0.05)(D, F)),
            "w_up": _w((lambda *s: torch.randn(*s, dtype=torch.bfloat16) * 0.05)(D, F)),
            "w_down": _w((lambda *s: torch.randn(*s, dtype=torch.bfloat16) * 0.05)(F, D)),
        }
    _B_in = _B_setup()

    return {
        "A_x": _A_in["x"],
        "A_k_cache": _A_in["k_cache"],
        "A_v_cache": _A_in["v_cache"],
        "A_wq": _A_in["wq"],
        "A_wo": _A_in["wo"],
        "B_x": _B_in["x"],
        "B_w_gate": _B_in["w_gate"],
        "B_w_up": _B_in["w_up"],
        "B_w_down": _B_in["w_down"],
    }

def reference(A_x, A_k_cache, A_v_cache, A_wq, A_wo, B_x, B_w_gate, B_w_up, B_w_down):
    def _A_ref(x, k_cache, v_cache, wq, wo):
        B, Sq, D = x.shape
        Hq, Dh = 32, 128
        Hkv = k_cache.shape[1]
        rep = Hq // Hkv
        q = (lambda x, *d: x.permute(*d))((x @ wq).reshape(B, Sq, Hq, Dh), 0, 2, 1, 3)
        k = (lambda x, n, axis: torch.repeat_interleave(x, n, dim=axis))(k_cache, rep, axis=1)
        v = (lambda x, n, axis: torch.repeat_interleave(x, n, dim=axis))(v_cache, rep, axis=1)
        scores = torch.einsum("bhqd,bhkd->bhqk", q, k) * (Dh ** -0.5)
        p = _softmax(scores, axis=-1)
        o = torch.einsum("bhqk,bhkd->bhqd", p, v)
        return (lambda x, *d: x.permute(*d))(o, 0, 2, 1, 3).reshape(B, Sq, Hq * Dh) @ wo

    def _B_ref(x, w_gate, w_up, w_down):
        g = _silu(x @ w_gate)
        u = x @ w_up
        return (g * u) @ w_down

    x = A_x
    h = x + _A_ref(_layernorm(x, axis=-1), A_k_cache, A_v_cache, A_wq, A_wo)
    h2 = h + _B_ref(_layernorm(h, axis=-1), B_w_gate, B_w_up, B_w_down)
    return h2
```

```asm
; @launch grid=(256,1,1) block=(512,1,1) lds=55552
.amdgcn_target "amdgcn-amd-amdhsa--gfx950"
.text
.globl sequential_preLN__gqa_block_cached__swiglu_ffn__decode_kernel
.p2align 8
.type sequential_preLN__gqa_block_cached__swiglu_ffn__decode_kernel,@function
sequential_preLN__gqa_block_cached__swiglu_ffn__decode_kernel:
s_cmp_ge_u32 s2, 256
s_cbranch_scc1 L_end
s_load_dwordx16 s[4:19], s[0:1], 0
s_load_dwordx8 s[20:27], s[0:1], 64
v_lshrrev_b32 v5, 6, v0
v_and_b32 v0, 63, v0
v_readfirstlane_b32 s3, v5
v_and_b32 v9, 60, v0
v_lshl_add_u32 v7, v5, 6, v9
v_lshlrev_b32 v2, 4, v0
v_and_b32 v6, 3, v0
v_lshlrev_b32 v8, 1, v7
v_lshlrev_b32 v9, 13, v7
v_lshl_add_u32 v9, v6, 4, v9
v_bfe_u32 v1, v0, 2, 2
v_lshlrev_b32 v1, 8, v1
v_lshl_add_u32 v1, v6, 4, v1
v_lshrrev_b32 v10, 4, v0
v_lshl_add_u32 v1, v10, 6, v1
s_and_b32 s99, s2, 7
s_mov_b32 s54, s99
s_lshr_b32 s53, s2, 7
s_bfe_u32 s85, s2, 0x40003
s_mov_b32 s52, s85
s_lshl_b32 s84, s53, 3
s_add_u32 s84, s84, s99
s_lshl_b32 s28, s53, 10
s_lshl_b32 s29, s54, 10
s_lshl_b32 s30, s85, 6
s_add_u32 s29, s29, s30
s_and_b32 s32, s52, 7
s_mul_i32 s30, s32, 532480
s_mul_i32 s31, s32, 516096
s_add_u32 s31, s31, 4259840
s_cmp_lt_u32 s52, 8
s_cselect_b32 s30, s30, s31
s_movk_i32 s91, 126
s_cselect_b32 s91, 130, s91
s_lshl_b32 s31, s84, 23
s_add_u32 s30, s30, s31
s_lshl_b32 s70, s91, 12
s_mov_b32 s74, s70
s_sub_u32 s91, s91, s3
s_add_u32 s91, s91, 7
s_lshr_b32 s91, s91, 3
s_lshl_b32 s97, s91, 15
s_lshl_b32 s90, s3, 12
s_lshl_b32 s31, s84, 4
s_add_u32 s31, s31, s52
s_mul_i32 s31, s31, 3
s_and_b32 s31, s31, 15
s_min_u32 s31, s31, 14
s_lshl_b32 s31, s31, 15
s_add_u32 s90, s90, s31
s_mov_b32 s71, 0x20000
s_mov_b32 s75, 0x20000
s_waitcnt lgkmcnt(0)
s_add_u32 s36, s4, s28
s_addc_u32 s37, s5, 0
global_load_dwordx4 v[112:115], v2, s[36:37]
global_load_dwordx2 v[116:117], v8, s[36:37]
s_add_u32 s38, s10, s29
s_addc_u32 s39, s11, 0
global_load_dwordx4 v[96:99], v9, s[38:39] nt
s_add_u32 s40, s38, 8192
s_addc_u32 s41, s39, 0
global_load_dwordx4 v[100:103], v9, s[40:41] nt
s_add_u32 s42, s38, 16384
s_addc_u32 s43, s39, 0
global_load_dwordx4 v[104:107], v9, s[42:43] nt
s_add_u32 s44, s38, 24576
s_addc_u32 s45, s39, 0
global_load_dwordx4 v[108:111], v9, s[44:45] nt
s_add_u32 s68, s6, s30
s_addc_u32 s69, s7, 0
s_add_u32 s72, s8, s30
s_addc_u32 s73, s9, 0
buffer_load_dwordx4 v[64:67], v1, s[68:71], s90 offen offset:0 nt
buffer_load_dwordx4 v[68:71], v1, s[68:71], s90 offen offset:1024 nt
buffer_load_dwordx4 v[72:75], v1, s[68:71], s90 offen offset:2048 nt
buffer_load_dwordx4 v[76:79], v1, s[68:71], s90 offen offset:3072 nt
buffer_load_dwordx4 v[80:83], v2, s[72:75], s90 offen offset:0 nt
buffer_load_dwordx4 v[84:87], v2, s[72:75], s90 offen offset:1024 nt
buffer_load_dwordx4 v[88:91], v2, s[72:75], s90 offen offset:2048 nt
buffer_load_dwordx4 v[92:95], v2, s[72:75], s90 offen offset:3072 nt
s_add_u32 s90, s90, 0x8000
s_sub_u32 s33, s90, s97
s_cselect_b32 s90, s90, s33
s_cmp_gt_u32 s91, 3
s_cselect_b32 s90, s90, 0x7ff00000
s_load_dword s89, s[26:27], 0
s_mov_b64 s[76:77], s[4:5]
s_mov_b64 s[78:79], s[22:23]
s_mov_b64 s[80:81], s[26:27]
s_mov_b64 s[100:101], s[20:21]
v_and_b32 v8, 1, v0
v_lshlrev_b32 v8, 4, v8
v_mov_b32 v9, 0xffff
v_lshlrev_b32 v8, v8, v9
v_and_b32 v9, 2, v0
v_cmp_eq_u32 vcc, 0, v9
s_nop 1
v_cndmask_b32 v3, 0, v8, vcc
v_cndmask_b32 v4, v8, 0, vcc
s_mov_b32 s86, 0x3db504f3
s_mov_b32 s87, 0x3fb8aa3b
s_mov_b32 s88, 0xffff0000
s_mov_b32 s82, 0x00f0000f
s_mov_b32 s83, 0xf0000f00
s_lshl_b32 s28, s53, 3
s_and_b32 s32, s52, 7
s_add_u32 s28, s28, s32
s_lshr_b32 s30, s28, 2
s_lshl_b32 s30, s30, 3
s_add_u32 s30, s30, s99
s_cmp_lt_u32 s30, 28
s_cselect_b32 s93, 1, 0
s_cmp_eq_u32 s53, 0
s_cselect_b32 s29, 2, 0
s_cmp_lt_u32 s52, 8
s_cselect_b32 s93, s93, s29
s_and_b32 s31, s28, 3
s_lshl_b32 s92, s30, 2
s_add_u32 s92, s92, s31
s_lshl_b32 s94, s99, 3
s_add_u32 s94, s94, s32
s_getreg_b32 s95, hwreg(HW_REG_XCC_ID, 0, 4)
v_lshrrev_b32 v9, 4, v0
v_lshl_add_u32 v9, s3, 2, v9
v_lshlrev_b32 v30, 7, v9
v_lshl_add_u32 v30, v6, 5, v30
v_lshlrev_b32 v31, 5, v6
v_bfe_u32 v9, v0, 2, 1
v_lshl_add_u32 v31, v9, 4, v31
v_bfe_u32 v9, v0, 3, 2
v_lshl_add_u32 v31, v9, 2, v31
v_lshrrev_b32 v9, 5, v0
v_lshl_add_u32 v31, v9, 11, v31
s_waitcnt vmcnt(12)
v_lshlrev_b32 v118, 16, v112
v_and_b32 v119, s88, v112
v_lshlrev_b32 v120, 16, v113
v_and_b32 v121, s88, v113
v_lshlrev_b32 v122, 16, v114
v_and_b32 v123, s88, v114
v_lshlrev_b32 v124, 16, v115
v_and_b32 v125, s88, v115
v_add_f32 v20, v118, v119
v_add_f32 v21, v120, v121
v_add_f32 v22, v122, v123
v_add_f32 v23, v124, v125
v_add_f32 v20, v20, v21
v_add_f32 v22, v22, v23
v_add_f32 v20, v20, v22
s_nop 1
v_add_f32_dpp v20, v20, v20 row_ror:1 row_mask:0xf bank_mask:0xf
s_nop 1
v_add_f32_dpp v20, v20, v20 row_ror:2 row_mask:0xf bank_mask:0xf
s_nop 1
v_add_f32_dpp v20, v20, v20 row_ror:4 row_mask:0xf bank_mask:0xf
s_nop 1
v_add_f32_dpp v20, v20, v20 row_ror:8 row_mask:0xf bank_mask:0xf
v_mov_b32 v21, v20
s_nop 1
v_permlane16_swap_b32 v20, v21
v_add_f32 v20, v20, v21
v_mov_b32 v21, v20
s_nop 1
v_permlane32_swap_b32 v20, v21
v_add_f32 v20, v20, v21
v_mul_f32 v20, 0x3b000000, v20
v_sub_f32 v118, v118, v20
v_sub_f32 v119, v119, v20
v_sub_f32 v120, v120, v20
v_sub_f32 v121, v121, v20
v_sub_f32 v122, v122, v20
v_sub_f32 v123, v123, v20
v_sub_f32 v124, v124, v20
v_sub_f32 v125, v125, v20
v_mul_f32 v22, v118, v118
v_mul_f32 v23, v119, v119
v_fmac_f32 v22, v120, v120
v_fmac_f32 v23, v121, v121
v_fmac_f32 v22, v122, v122
v_fmac_f32 v23, v123, v123
v_fmac_f32 v22, v124, v124
v_fmac_f32 v23, v125, v125
v_add_f32 v22, v22, v23
s_nop 1
v_add_f32_dpp v22, v22, v22 row_ror:1 row_mask:0xf bank_mask:0xf
s_nop 1
v_add_f32_dpp v22, v22, v22 row_ror:2 row_mask:0xf bank_mask:0xf
s_nop 1
v_add_f32_dpp v22, v22, v22 row_ror:4 row_mask:0xf bank_mask:0xf
s_nop 1
v_add_f32_dpp v22, v22, v22 row_ror:8 row_mask:0xf bank_mask:0xf
v_mov_b32 v21, v22
s_nop 1
v_permlane16_swap_b32 v22, v21
v_add_f32 v22, v22, v21
v_mov_b32 v21, v22
s_nop 1
v_permlane32_swap_b32 v22, v21
v_add_f32 v22, v22, v21
v_mul_f32 v22, 0x3b000000, v22
v_cvt_pk_bf16_f32 v22, v20, v22
v_lshlrev_b32 v20, 16, v22
v_and_b32 v22, s88, v22
v_add_f32 v22, 0x3727c5ac, v22
v_cvt_pk_bf16_f32 v22, v22, v22
v_and_b32 v22, s88, v22
v_sqrt_f32 v23, v22
s_nop 0
v_cvt_pk_bf16_f32 v23, v23, v23
v_and_b32 v23, s88, v23
v_rcp_f32 v21, v23
v_lshlrev_b32 v118, 16, v116
v_and_b32 v119, s88, v116
v_lshlrev_b32 v120, 16, v117
v_and_b32 v121, s88, v117
v_sub_f32 v118, v118, v20
v_sub_f32 v119, v119, v20
v_sub_f32 v120, v120, v20
v_sub_f32 v121, v121, v20
v_cvt_pk_bf16_f32 v118, v118, v119
v_cvt_pk_bf16_f32 v120, v120, v121
v_and_b32 v119, s88, v118
v_and_b32 v121, s88, v120
v_lshlrev_b32 v118, 16, v118
v_lshlrev_b32 v120, 16, v120
v_mul_f32 v122, v118, v21
v_mul_f32 v123, v119, v21
v_mul_f32 v124, v120, v21
v_mul_f32 v125, v121, v21
v_fma_f32 v118, -v122, v23, v118
v_fma_f32 v119, -v123, v23, v119
v_fma_f32 v120, -v124, v23, v120
v_fma_f32 v121, -v125, v23, v121
v_fma_f32 v122, v118, v21, v122
v_fma_f32 v123, v119, v21, v123
v_fma_f32 v124, v120, v21, v124
v_fma_f32 v125, v121, v21, v125
v_cvt_pk_bf16_f32 v24, v122, v122
v_cvt_pk_bf16_f32 v25, v123, v123
v_cvt_pk_bf16_f32 v26, v124, v124
v_cvt_pk_bf16_f32 v27, v125, v125
s_waitcnt vmcnt(8)
v_and_b32 v118, v24, v3
v_and_b32 v119, v24, v4
v_and_b32 v120, v25, v3
v_and_b32 v121, v25, v4
v_and_b32 v122, v26, v3
v_and_b32 v123, v26, v4
v_and_b32 v124, v27, v3
v_and_b32 v125, v27, v4
v_mfma_f32_16x16x16_bf16 v[12:15], v[96:97], v[118:119], 0
v_mfma_f32_16x16x16_bf16 v[16:19], v[98:99], v[118:119], 0
v_mfma_f32_16x16x16_bf16 v[12:15], v[100:101], v[120:121], v[12:15]
v_mfma_f32_16x16x16_bf16 v[16:19], v[102:103], v[120:121], v[16:19]
v_mfma_f32_16x16x16_bf16 v[12:15], v[104:105], v[122:123], v[12:15]
v_mfma_f32_16x16x16_bf16 v[16:19], v[106:107], v[122:123], v[16:19]
v_mfma_f32_16x16x16_bf16 v[12:15], v[108:109], v[124:125], v[12:15]
v_mfma_f32_16x16x16_bf16 v[16:19], v[110:111], v[124:125], v[16:19]
s_mov_b64 exec, s[82:83]
s_nop 5
ds_write_b128 v30, v[12:15] offset:0
ds_write_b128 v30, v[16:19] offset:16
s_mov_b64 exec, -1
s_waitcnt lgkmcnt(0)
s_barrier
s_add_u32 s89, s89, 1
s_lshl_b32 s28, s89, 4
s_or_b32 s95, s95, s28
s_cmp_lg_u32 s3, 0
s_cbranch_scc1 L_noq
ds_read_b32 v96, v31 offset:0
ds_read_b32 v97, v31 offset:128
ds_read_b32 v98, v31 offset:256
ds_read_b32 v99, v31 offset:384
ds_read_b32 v100, v31 offset:512
ds_read_b32 v101, v31 offset:640
ds_read_b32 v102, v31 offset:768
ds_read_b32 v103, v31 offset:896
ds_read_b32 v104, v31 offset:1024
ds_read_b32 v105, v31 offset:1152
ds_read_b32 v106, v31 offset:1280
ds_read_b32 v107, v31 offset:1408
ds_read_b32 v108, v31 offset:1536
ds_read_b32 v109, v31 offset:1664
ds_read_b32 v110, v31 offset:1792
ds_read_b32 v111, v31 offset:1920
s_waitcnt lgkmcnt(8)
v_add_f32 v96, v96, v97
v_add_f32 v98, v98, v99
v_add_f32 v100, v100, v101
v_add_f32 v102, v102, v103
v_add_f32 v96, v96, v98
v_add_f32 v100, v100, v102
v_add_f32 v96, v96, v100
s_waitcnt lgkmcnt(0)
v_add_f32 v104, v104, v105
v_add_f32 v106, v106, v107
v_add_f32 v108, v108, v109
v_add_f32 v110, v110, v111
v_add_f32 v104, v104, v106
v_add_f32 v108, v108, v110
v_add_f32 v104, v104, v108
v_add_f32 v20, v96, v104
v_mov_b32 v96, v20
s_nop 1
v_permlane32_swap_b32 v20, v96
v_add_f32 v20, v20, v96
s_nop 1
v_mov_b32_dpp v21, v20 quad_perm:[1,1,3,3] row_mask:0xf bank_mask:0xf
v_cvt_pk_bf16_f32 v22, v20, v21
v_mov_b32 v23, s89
s_lshl_b32 s28, s84, 11
s_lshl_b32 s29, s85, 7
s_add_u32 s28, s28, s29
s_add_u32 s28, s28, 4096
s_add_u32 s36, s80, s28
s_addc_u32 s37, s81, 0
v_lshlrev_b32 v9, 2, v0
s_mov_b64 exec, 0x55555555
global_store_dwordx2 v9, v[22:23], s[36:37] sc1
s_mov_b64 exec, 1
s_lshl_b32 s28, s99, 7
s_lshr_b32 s29, s2, 3
s_lshl_b32 s29, s29, 2
s_add_u32 s28, s28, s29
v_mov_b32 v9, s28
v_mov_b32 v22, s95
global_store_dword v9, v22, s[80:81] offset:1024 sc1
s_mov_b64 exec, -1
L_noq:
v_lshrrev_b32 v20, 2, v7
v_lshrrev_b32 v21, 3, v20
v_lshlrev_b32 v21, 5, v21
v_and_b32 v20, 7, v20
v_add_u32 v21, v21, v20
v_mul_u32_u24 v21, 0xe00, v21
v_and_b32 v22, 1, v0
v_lshl_add_u32 v21, v22, 4, v21
s_lshl_b32 s28, s92, 5
v_add_u32 v21, s28, v21
v_cmp_gt_u32 vcc, 2, v6
v_mov_b32 v22, s18
v_mov_b32 v23, s16
v_cndmask_b32 v22, v22, v23, vcc
v_mov_b32 v23, s19
v_mov_b32 v24, s17
v_cndmask_b32 v23, v23, v24, vcc
v_add_co_u32 v48, vcc, v22, v21
s_nop 1
v_addc_co_u32 v49, vcc, 0, v23, vcc
s_cmp_lt_u32 s52, 8
s_cbranch_scc1 L_nwo
s_lshl_b32 s28, s54, 19
s_bfe_u32 s29, s52, 0x20001
s_lshl_b32 s29, s29, 17
s_add_u32 s28, s28, s29
s_lshl_b32 s29, s3, 14
s_add_u32 s28, s28, s29
s_and_b32 s29, s52, 1
s_lshl_b32 s29, s29, 9
s_add_u32 s28, s28, s29
s_add_u32 s36, s12, s28
s_addc_u32 s37, s13, 0
v_lshrrev_b32 v20, 4, v0
v_lshlrev_b32 v20, 12, v20
v_and_b32 v21, 15, v0
v_lshl_add_u32 v21, v21, 4, v20
global_load_dwordx4 v[32:35], v21, s[36:37] offset:0 nt
global_load_dwordx4 v[48:51], v21, s[36:37] offset:256 nt
global_load_dwordx4 v[36:39], v21, s[36:37] offset:1024 nt
global_load_dwordx4 v[52:55], v21, s[36:37] offset:1280 nt
global_load_dwordx4 v[40:43], v21, s[36:37] offset:2048 nt
global_load_dwordx4 v[56:59], v21, s[36:37] offset:2304 nt
global_load_dwordx4 v[44:47], v21, s[36:37] offset:3072 nt
global_load_dwordx4 v[60:63], v21, s[36:37] offset:3328 nt
L_nwo:
buffer_load_dwordx4 v[96:99], v1, s[68:71], s90 offen offset:0 nt
buffer_load_dwordx4 v[100:103], v1, s[68:71], s90 offen offset:1024 nt
buffer_load_dwordx4 v[104:107], v1, s[68:71], s90 offen offset:2048 nt
buffer_load_dwordx4 v[108:111], v1, s[68:71], s90 offen offset:3072 nt
buffer_load_dwordx4 v[112:115], v2, s[72:75], s90 offen offset:0 nt
buffer_load_dwordx4 v[116:119], v2, s[72:75], s90 offen offset:1024 nt
buffer_load_dwordx4 v[120:123], v2, s[72:75], s90 offen offset:2048 nt
buffer_load_dwordx4 v[124:127], v2, s[72:75], s90 offen offset:3072 nt
s_add_u32 s90, s90, 0x8000
s_sub_u32 s33, s90, s97
s_cselect_b32 s90, s90, s33
s_cmp_gt_u32 s91, 3
s_cselect_b32 s90, s90, 0x7ff00000
v_mov_b32 v12, 0
v_mov_b32 v13, 0
v_mov_b32 v14, 0
v_mov_b32 v15, 0
v_mov_b32 v16, 0
v_mov_b32 v17, 0
v_mov_b32 v18, 0
v_mov_b32 v19, 0
v_mov_b32 v5, 0xff800000
v_mov_b32 v6, 0
s_lshl_b32 s96, s84, 11
s_lshl_b32 s98, s3, 8
s_add_u32 s96, s96, s98
s_add_u32 s96, s96, 4096
s_add_u32 s0, s80, s96
s_addc_u32 s1, s81, 0
v_lshrrev_b32 v9, 1, v0
v_lshl_add_u32 v9, s3, 5, v9
v_lshlrev_b32 v9, 2, v9
v_bfe_u32 v10, v0, 2, 2
v_lshlrev_b32 v28, 8, v10
v_lshrrev_b32 v10, 4, v0
v_lshl_add_u32 v28, v10, 6, v28
v_and_b32 v10, 3, v0
v_lshl_add_u32 v28, v10, 4, v28
v_and_b32 v10, 1, v0
v_cmp_eq_u32 vcc, 1, v10
v_mov_b32 v11, s89
s_nop 0
v_cndmask_b32 v11, 0, v11, vcc
v_cndmask_b32 v10, 0, -1, vcc
s_mov_b32 s98, 0
L_qpoll:
s_load_dwordx16 s[4:19], s[0:1], 0 glc
s_load_dwordx16 s[20:35], s[0:1], 64 glc
s_load_dwordx16 s[36:51], s[0:1], 128 glc
s_load_dwordx16 s[52:67], s[0:1], 192 glc
s_waitcnt lgkmcnt(0)
s_cmp_eq_u32 s35, s89
s_cbranch_scc0 L_qretry
s_cmp_eq_u32 s67, s89
s_cbranch_scc0 L_qretry
v_writelane_b32 v8, s4, 0
v_writelane_b32 v8, s5, 1
v_writelane_b32 v8, s6, 2
v_writelane_b32 v8, s7, 3
v_writelane_b32 v8, s8, 4
v_writelane_b32 v8, s9, 5
v_writelane_b32 v8, s10, 6
v_writelane_b32 v8, s11, 7
v_writelane_b32 v8, s12, 8
v_writelane_b32 v8, s13, 9
v_writelane_b32 v8, s14, 10
v_writelane_b32 v8, s15, 11
v_writelane_b32 v8, s16, 12
v_writelane_b32 v8, s17, 13
v_writelane_b32 v8, s18, 14
v_writelane_b32 v8, s19, 15
v_writelane_b32 v8, s20, 16
v_writelane_b32 v8, s21, 17
v_writelane_b32 v8, s22, 18
v_writelane_b32 v8, s23, 19
v_writelane_b32 v8, s24, 20
v_writelane_b32 v8, s25, 21
v_writelane_b32 v8, s26, 22
v_writelane_b32 v8, s27, 23
v_writelane_b32 v8, s28, 24
v_writelane_b32 v8, s29, 25
v_writelane_b32 v8, s30, 26
v_writelane_b32 v8, s31, 27
v_writelane_b32 v8, s32, 28
v_writelane_b32 v8, s33, 29
v_writelane_b32 v8, s34, 30
v_writelane_b32 v8, s35, 31
v_writelane_b32 v8, s36, 32
v_writelane_b32 v8, s37, 33
v_writelane_b32 v8, s38, 34
v_writelane_b32 v8, s39, 35
v_writelane_b32 v8, s40, 36
v_writelane_b32 v8, s41, 37
v_writelane_b32 v8, s42, 38
v_writelane_b32 v8, s43, 39
v_writelane_b32 v8, s44, 40
v_writelane_b32 v8, s45, 41
v_writelane_b32 v8, s46, 42
v_writelane_b32 v8, s47, 43
v_writelane_b32 v8, s48, 44
v_writelane_b32 v8, s49, 45
v_writelane_b32 v8, s50, 46
v_writelane_b32 v8, s51, 47
v_writelane_b32 v8, s52, 48
v_writelane_b32 v8, s53, 49
v_writelane_b32 v8, s54, 50
v_writelane_b32 v8, s55, 51
v_writelane_b32 v8, s56, 52
v_writelane_b32 v8, s57, 53
v_writelane_b32 v8, s58, 54
v_writelane_b32 v8, s59, 55
v_writelane_b32 v8, s60, 56
v_writelane_b32 v8, s61, 57
v_writelane_b32 v8, s62, 58
v_writelane_b32 v8, s63, 59
v_writelane_b32 v8, s64, 60
v_writelane_b32 v8, s65, 61
v_writelane_b32 v8, s66, 62
v_writelane_b32 v8, s67, 63
v_and_b32 v20, v8, v10
v_cmp_ne_u32 vcc, v20, v11
s_cbranch_vccz L_qok
L_qretry:
s_add_u32 s98, s98, 1
s_cmp_ge_u32 s98, 262144
s_cbranch_scc1 L_qok
s_sleep 4
s_branch L_qpoll
L_qok:
s_mov_b32 s32, 0x55555555
s_mov_b32 s33, 0x55555555
s_mov_b64 exec, s[32:33]
ds_write_b32 v9, v8 offset:25600
s_mov_b64 exec, -1
s_waitcnt lgkmcnt(0)
s_barrier
ds_read_b128 v[8:11], v28 offset:25600
s_lshl_b32 s28, s99, 7
s_add_u32 s0, s80, s28
s_addc_u32 s1, s81, 0
s_waitcnt lgkmcnt(0)
v_bfe_u32 v28, v0, 2, 2
v_lshrrev_b32 v29, 4, v0
v_and_b32 v30, 3, v0
v_lshl_add_u32 v31, v28, 2, v29
v_lshlrev_b32 v20, 7, v31
v_and_b32 v31, 7, v31
v_lshl_add_u32 v20, v31, 4, v20
v_lshl_add_u32 v20, v30, 2, v20
s_lshl_b32 s28, s3, 11
v_add_u32 v20, s28, v20
v_lshlrev_b32 v21, 6, v28
s_lshl_b32 s28, s3, 3
v_add_u32 v21, s28, v21
v_lshrrev_b32 v31, 2, v0
v_lshl_add_u32 v31, s3, 4, v31
v_lshrrev_b32 v22, 3, v31
v_and_b32 v22, 7, v22
v_xor_b32 v22, v22, v31
v_lshlrev_b32 v22, 4, v22
v_lshl_add_u32 v22, v30, 12, v22
s_lshr_b32 s30, s3, 1
s_lshl_b32 s28, s30, 6
v_lshlrev_b32 v23, 4, v30
v_add_u32 v23, s28, v23
v_mul_u32_u24 v24, 1280, v29
v_lshl_add_u32 v24, v28, 4, v24
v_lshl_add_u32 v24, v30, 6, v24
v_and_b32 v31, 15, v0
v_mul_u32_u24 v26, 80, v31
v_lshl_add_u32 v25, v29, 4, v26
v_and_b32 v31, 7, v0
v_lshl_add_u32 v27, v29, 3, v31
v_lshlrev_b32 v27, 4, v27
s_mul_i32 s28, s3, 1040
v_add_u32 v27, s28, v27
s_lshl_b32 s28, s3, 10
v_add_u32 v7, s28, v2
ds_write_b128 v7, v[20:23] offset:30976
ds_write_b128 v7, v[24:27] offset:39168
v_and_b32 v20, 4, v0
v_cmp_eq_u32 vcc, 0, v20
s_nop 1
v_cndmask_b32 v24, 0, v3, vcc
v_cndmask_b32 v25, 0, v4, vcc
v_cndmask_b32 v26, v3, 0, vcc
v_cndmask_b32 v27, v4, 0, vcc
ds_write_b128 v7, v[24:27] offset:47360
v_lshrrev_b32 v20, 3, v0
v_lshl_add_u32 v20, s3, 3, v20
v_lshlrev_b32 v30, 4, v20
v_mul_u32_u24 v31, 1040, v31
v_add_u32 v31, v31, v30
s_lshl_b32 s28, s84, 2
s_add_u32 s28, s28, s30
s_mul_i32 s28, s28, 10240
s_and_b32 s29, s3, 1
s_mul_i32 s29, s29, 5120
s_add_u32 s28, s28, s29
s_mul_i32 s29, s85, 80
s_add_u32 s28, s28, s29
s_add_u32 s28, s28, 1048576
s_add_u32 s4, s80, s28
s_addc_u32 s5, s81, 0
s_lshl_b32 s28, s84, 2
s_bfe_u32 s29, s85, 0x20001
s_add_u32 s28, s28, s29
s_mul_i32 s28, s28, 10240
s_mul_i32 s29, s3, 1280
s_add_u32 s28, s28, s29
s_add_u32 s28, s28, 1048576
s_add_u32 s6, s80, s28
s_addc_u32 s7, s81, 0
s_lshl_b32 s28, s84, 13
s_and_b32 s29, s85, 7
s_lshl_b32 s29, s29, 10
s_add_u32 s28, s28, s29
s_add_u32 s28, s28, 262144
s_add_u32 s8, s80, s28
s_addc_u32 s9, s81, 0
s_mul_i32 s28, s99, 4352
s_add_u32 s28, s28, 65536
s_add_u32 s10, s80, s28
s_addc_u32 s11, s81, 0
s_mov_b32 s12, 0x11131113
s_mov_b32 s13, 0x11131113
s_mov_b32 s14, 0x00ff00ff
s_mov_b32 s15, 0x00ff00ff
s_mov_b32 s16, 0x01010101
s_mov_b32 s17, 0x01010101
s_mov_b32 s18, 0x22222222
s_mov_b32 s19, 0x22222222
s_and_b32 s20, s89, 0xff
s_mov_b32 s98, 0
L_loop:
s_waitcnt vmcnt(12)
v_mfma_f32_16x16x32_bf16 v[20:23], v[64:67], v[8:11], 0
v_mfma_f32_16x16x32_bf16 v[64:67], v[68:71], v[8:11], 0
v_mfma_f32_16x16x32_bf16 v[68:71], v[72:75], v[8:11], 0
v_mfma_f32_16x16x32_bf16 v[72:75], v[76:79], v[8:11], 0
s_nop 4
v_mov_b32_dpp v24, v20 quad_perm:[0,0,0,0] row_mask:0xf bank_mask:0xf
v_mov_b32_dpp v25, v64 quad_perm:[0,0,0,0] row_mask:0xf bank_mask:0xf
v_mov_b32_dpp v26, v68 quad_perm:[0,0,0,0] row_mask:0xf bank_mask:0xf
v_mov_b32_dpp v27, v72 quad_perm:[0,0,0,0] row_mask:0xf bank_mask:0xf
v_add_f32_dpp v24, v21, v24 quad_perm:[1,1,1,1] row_mask:0xf bank_mask:0xf
v_add_f32_dpp v25, v65, v25 quad_perm:[1,1,1,1] row_mask:0xf bank_mask:0xf
v_add_f32_dpp v26, v69, v26 quad_perm:[1,1,1,1] row_mask:0xf bank_mask:0xf
v_add_f32_dpp v27, v73, v27 quad_perm:[1,1,1,1] row_mask:0xf bank_mask:0xf
v_add_f32_dpp v24, v22, v24 quad_perm:[2,2,2,2] row_mask:0xf bank_mask:0xf
v_add_f32_dpp v25, v66, v25 quad_perm:[2,2,2,2] row_mask:0xf bank_mask:0xf
v_add_f32_dpp v26, v70, v26 quad_perm:[2,2,2,2] row_mask:0xf bank_mask:0xf
v_add_f32_dpp v27, v74, v27 quad_perm:[2,2,2,2] row_mask:0xf bank_mask:0xf
v_add_f32_dpp v24, v23, v24 quad_perm:[3,3,3,3] row_mask:0xf bank_mask:0xf
v_add_f32_dpp v25, v67, v25 quad_perm:[3,3,3,3] row_mask:0xf bank_mask:0xf
v_add_f32_dpp v26, v71, v26 quad_perm:[3,3,3,3] row_mask:0xf bank_mask:0xf
v_add_f32_dpp v27, v75, v27 quad_perm:[3,3,3,3] row_mask:0xf bank_mask:0xf
buffer_load_dwordx4 v[64:67], v1, s[68:71], s90 offen offset:0 nt
buffer_load_dwordx4 v[68:71], v1, s[68:71], s90 offen offset:1024 nt
buffer_load_dwordx4 v[72:75], v1, s[68:71], s90 offen offset:2048 nt
buffer_load_dwordx4 v[76:79], v1, s[68:71], s90 offen offset:3072 nt
v_cvt_pk_bf16_f32 v24, v24, v25
v_cvt_pk_bf16_f32 v26, v26, v27
v_and_b32 v25, s88, v24
v_and_b32 v27, s88, v26
v_lshlrev_b32 v24, 16, v24
v_lshlrev_b32 v26, 16, v26
v_mul_f32 v24, s86, v24
v_mul_f32 v25, s86, v25
v_mul_f32 v26, s86, v26
v_mul_f32 v27, s86, v27
v_cvt_pk_bf16_f32 v24, v24, v25
v_cvt_pk_bf16_f32 v26, v26, v27
v_and_b32 v25, s88, v24
v_and_b32 v27, s88, v26
v_lshlrev_b32 v24, 16, v24
v_lshlrev_b32 v26, 16, v26
v_max3_f32 v22, v24, v25, v26
v_max3_f32 v22, v22, v27, v5
v_mov_b32 v23, v22
s_nop 1
v_permlane16_swap_b32 v22, v23
v_max_f32 v22, v22, v23
v_mov_b32 v23, v22
s_nop 1
v_permlane32_swap_b32 v22, v23
v_max_f32 v22, v22, v23
v_sub_f32 v23, v5, v22
v_mul_f32 v23, s87, v23
v_mov_b32 v5, v22
v_exp_f32 v28, v23
v_sub_f32 v24, v24, v22
v_sub_f32 v25, v25, v22
v_sub_f32 v26, v26, v22
v_sub_f32 v27, v27, v22
v_mul_f32 v24, s87, v24
v_mul_f32 v25, s87, v25
v_mul_f32 v26, s87, v26
v_mul_f32 v27, s87, v27
v_exp_f32 v24, v24
v_exp_f32 v25, v25
v_exp_f32 v26, v26
v_exp_f32 v27, v27
v_pk_mul_f32 v[12:13], v[12:13], v[28:29] op_sel_hi:[1,0]
v_pk_mul_f32 v[14:15], v[14:15], v[28:29] op_sel_hi:[1,0]
v_pk_mul_f32 v[16:17], v[16:17], v[28:29] op_sel_hi:[1,0]
v_pk_mul_f32 v[18:19], v[18:19], v[28:29] op_sel_hi:[1,0]
v_fma_f32 v6, v6, v28, v24
v_add_f32 v29, v25, v26
v_add_f32 v6, v6, v27
v_add_f32 v6, v6, v29
v_cvt_pk_bf16_f32 v24, v24, v24
v_cvt_pk_bf16_f32 v25, v25, v25
v_cvt_pk_bf16_f32 v26, v26, v26
v_cvt_pk_bf16_f32 v27, v27, v27
v_and_b32 v21, v27, v4
v_and_b32 v20, v27, v3
v_and_b32 v23, v26, v4
v_and_b32 v22, v26, v3
v_and_b32 v29, v25, v4
v_and_b32 v28, v25, v3
v_and_b32 v27, v24, v4
v_and_b32 v26, v24, v3
s_waitcnt vmcnt(12)
v_mfma_f32_16x16x16_bf16 v[12:15], v[92:93], v[20:21], v[12:15]
v_mfma_f32_16x16x16_bf16 v[16:19], v[94:95], v[20:21], v[16:19]
v_mfma_f32_16x16x16_bf16 v[12:15], v[88:89], v[22:23], v[12:15]
v_mfma_f32_16x16x16_bf16 v[16:19], v[90:91], v[22:23], v[16:19]
v_mfma_f32_16x16x16_bf16 v[12:15], v[84:85], v[28:29], v[12:15]
v_mfma_f32_16x16x16_bf16 v[16:19], v[86:87], v[28:29], v[16:19]
v_mfma_f32_16x16x16_bf16 v[12:15], v[80:81], v[26:27], v[12:15]
v_mfma_f32_16x16x16_bf16 v[16:19], v[82:83], v[26:27], v[16:19]
buffer_load_dwordx4 v[80:83], v2, s[72:75], s90 offen offset:0 nt
buffer_load_dwordx4 v[84:87], v2, s[72:75], s90 offen offset:1024 nt
buffer_load_dwordx4 v[88:91], v2, s[72:75], s90 offen offset:2048 nt
buffer_load_dwordx4 v[92:95], v2, s[72:75], s90 offen offset:3072 nt
s_add_u32 s90, s90, 0x8000
s_sub_u32 s33, s90, s97
s_cselect_b32 s90, s90, s33
s_cmp_gt_u32 s91, 3
s_cselect_b32 s90, s90, 0x7ff00000
s_sub_u32 s91, s91, 1
s_cmp_lg_u32 s91, 0
s_cbranch_scc0 L_loopend
s_waitcnt vmcnt(12)
v_mfma_f32_16x16x32_bf16 v[20:23], v[96:99], v[8:11], 0
v_mfma_f32_16x16x32_bf16 v[96:99], v[100:103], v[8:11], 0
v_mfma_f32_16x16x32_bf16 v[100:103], v[104:107], v[8:11], 0
v_mfma_f32_16x16x32_bf16 v[104:107], v[108:111], v[8:11], 0
s_nop 4
v_mov_b32_dpp v24, v20 quad_perm:[0,0,0,0] row_mask:0xf bank_mask:0xf
v_mov_b32_dpp v25, v96 quad_perm:[0,0,0,0] row_mask:0xf bank_mask:0xf
v_mov_b32_dpp v26, v100 quad_perm:[0,0,0,0] row_mask:0xf bank_mask:0xf
v_mov_b32_dpp v27, v104 quad_perm:[0,0,0,0] row_mask:0xf bank_mask:0xf
v_add_f32_dpp v24, v21, v24 quad_perm:[1,1,1,1] row_mask:0xf bank_mask:0xf
v_add_f32_dpp v25, v97, v25 quad_perm:[1,1,1,1] row_mask:0xf bank_mask:0xf
v_add_f32_dpp v26, v101, v26 quad_perm:[1,1,1,1] row_mask:0xf bank_mask:0xf
v_add_f32_dpp v27, v105, v27 quad_perm:[1,1,1,1] row_mask:0xf bank_mask:0xf
v_add_f32_dpp v24, v22, v24 quad_perm:[2,2,2,2] row_mask:0xf bank_mask:0xf
v_add_f32_dpp v25, v98, v25 quad_perm:[2,2,2,2] row_mask:0xf bank_mask:0xf
v_add_f32_dpp v26, v102, v26 quad_perm:[2,2,2,2] row_mask:0xf bank_mask:0xf
v_add_f32_dpp v27, v106, v27 quad_perm:[2,2,2,2] row_mask:0xf bank_mask:0xf
v_add_f32_dpp v24, v23, v24 quad_perm:[3,3,3,3] row_mask:0xf bank_mask:0xf
v_add_f32_dpp v25, v99, v25 quad_perm:[3,3,3,3] row_mask:0xf bank_mask:0xf
v_add_f32_dpp v26, v103, v26 quad_perm:[3,3,3,3] row_mask:0xf bank_mask:0xf
v_add_f32_dpp v27, v107, v27 quad_perm:[3,3,3,3] row_mask:0xf bank_mask:0xf
buffer_load_dwordx4 v[96:99], v1, s[68:71], s90 offen offset:0 nt
buffer_load_dwordx4 v[100:103], v1, s[68:71], s90 offen offset:1024 nt
buffer_load_dwordx4 v[104:107], v1, s[68:71], s90 offen offset:2048 nt
buffer_load_dwordx4 v[108:111], v1, s[68:71], s90 offen offset:3072 nt
v_cvt_pk_bf16_f32 v24, v24, v25
v_cvt_pk_bf16_f32 v26, v26, v27
v_and_b32 v25, s88, v24
v_and_b32 v27, s88, v26
v_lshlrev_b32 v24, 16, v24
v_lshlrev_b32 v26, 16, v26
v_mul_f32 v24, s86, v24
v_mul_f32 v25, s86, v25
v_mul_f32 v26, s86, v26
v_mul_f32 v27, s86, v27
v_cvt_pk_bf16_f32 v24, v24, v25
v_cvt_pk_bf16_f32 v26, v26, v27
v_and_b32 v25, s88, v24
v_and_b32 v27, s88, v26
v_lshlrev_b32 v24, 16, v24
v_lshlrev_b32 v26, 16, v26
v_max3_f32 v22, v24, v25, v26
v_max3_f32 v22, v22, v27, v5
v_mov_b32 v23, v22
s_nop 1
v_permlane16_swap_b32 v22, v23
v_max_f32 v22, v22, v23
v_mov_b32 v23, v22
s_nop 1
v_permlane32_swap_b32 v22, v23
v_max_f32 v22, v22, v23
v_sub_f32 v23, v5, v22
v_mul_f32 v23, s87, v23
v_mov_b32 v5, v22
v_exp_f32 v28, v23
v_sub_f32 v24, v24, v22
v_sub_f32 v25, v25, v22
v_sub_f32 v26, v26, v22
v_sub_f32 v27, v27, v22
v_mul_f32 v24, s87, v24
v_mul_f32 v25, s87, v25
v_mul_f32 v26, s87, v26
v_mul_f32 v27, s87, v27
v_exp_f32 v24, v24
v_exp_f32 v25, v25
v_exp_f32 v26, v26
v_exp_f32 v27, v27
v_pk_mul_f32 v[12:13], v[12:13], v[28:29] op_sel_hi:[1,0]
v_pk_mul_f32 v[14:15], v[14:15], v[28:29] op_sel_hi:[1,0]
v_pk_mul_f32 v[16:17], v[16:17], v[28:29] op_sel_hi:[1,0]
v_pk_mul_f32 v[18:19], v[18:19], v[28:29] op_sel_hi:[1,0]
v_fma_f32 v6, v6, v28, v24
v_add_f32 v29, v25, v26
v_add_f32 v6, v6, v27
v_add_f32 v6, v6, v29
v_cvt_pk_bf16_f32 v24, v24, v24
v_cvt_pk_bf16_f32 v25, v25, v25
v_cvt_pk_bf16_f32 v26, v26, v26
v_cvt_pk_bf16_f32 v27, v27, v27
v_and_b32 v21, v27, v4
v_and_b32 v20, v27, v3
v_and_b32 v23, v26, v4
v_and_b32 v22, v26, v3
v_and_b32 v29, v25, v4
v_and_b32 v28, v25, v3
v_and_b32 v27, v24, v4
v_and_b32 v26, v24, v3
s_waitcnt vmcnt(12)
v_mfma_f32_16x16x16_bf16 v[12:15], v[124:125], v[20:21], v[12:15]
v_mfma_f32_16x16x16_bf16 v[16:19], v[126:127], v[20:21], v[16:19]
v_mfma_f32_16x16x16_bf16 v[12:15], v[120:121], v[22:23], v[12:15]
v_mfma_f32_16x16x16_bf16 v[16:19], v[122:123], v[22:23], v[16:19]
v_mfma_f32_16x16x16_bf16 v[12:15], v[116:117], v[28:29], v[12:15]
v_mfma_f32_16x16x16_bf16 v[16:19], v[118:119], v[28:29], v[16:19]
v_mfma_f32_16x16x16_bf16 v[12:15], v[112:113], v[26:27], v[12:15]
v_mfma_f32_16x16x16_bf16 v[16:19], v[114:115], v[26:27], v[16:19]
buffer_load_dwordx4 v[112:115], v2, s[72:75], s90 offen offset:0 nt
buffer_load_dwordx4 v[116:119], v2, s[72:75], s90 offen offset:1024 nt
buffer_load_dwordx4 v[120:123], v2, s[72:75], s90 offen offset:2048 nt
buffer_load_dwordx4 v[124:127], v2, s[72:75], s90 offen offset:3072 nt
s_add_u32 s90, s90, 0x8000
s_sub_u32 s33, s90, s97
s_cselect_b32 s90, s90, s33
s_cmp_gt_u32 s91, 3
s_cselect_b32 s90, s90, 0x7ff00000
s_sub_u32 s91, s91, 1
s_cmp_lg_u32 s91, 0
s_cbranch_scc1 L_loop
L_loopend:
ds_read_b128 v[20:23], v7 offset:30976
v_mov_b32 v28, v6
s_nop 1
v_permlane16_swap_b32 v6, v28
v_add_f32 v6, v6, v28
v_mov_b32 v28, v6
s_nop 1
v_permlane32_swap_b32 v6, v28
v_add_f32 v6, v6, v28
v_mul_f32 v5, s87, v5
s_waitcnt vmcnt(0) lgkmcnt(0)
v_xor_b32 v24, 0, v20
ds_write_b32 v24, v12 offset:8192
v_xor_b32 v26, 32, v20
ds_write_b32 v26, v13 offset:8192
v_xor_b32 v24, 64, v20
ds_write_b32 v24, v14 offset:8192
v_xor_b32 v26, 96, v20
ds_write_b32 v26, v15 offset:8192
v_xor_b32 v25, 16, v20
ds_write_b32 v25, v16 offset:8192
v_xor_b32 v27, 48, v20
ds_write_b32 v27, v17 offset:8192
v_xor_b32 v25, 80, v20
ds_write_b32 v25, v18 offset:8192
v_xor_b32 v27, 112, v20
ds_write_b32 v27, v19 offset:8192
s_mov_b64 exec, 0x1111
ds_write_b32 v21, v5 offset:24576
ds_write_b32 v21, v6 offset:24580
s_mov_b64 exec, -1
ds_read_b128 v[112:115], v7 offset:39168
ds_read_b128 v[104:107], v7 offset:47360
v_mov_b32 v127, s20
v_mov_b32 v29, 0
s_mov_b32 s97, 0xffffff00
s_cmp_ge_u32 s3, 4
s_cbranch_scc1 L_late
s_cmp_lg_u32 s3, 0
s_cbranch_scc1 L_nxt
v_and_b32 v24, 31, v0
v_lshlrev_b32 v24, 2, v24
global_load_dword v25, v24, s[0:1] offset:1024 sc1
s_waitcnt vmcnt(0)
v_cmp_ne_u32 vcc, s95, v25
s_cmp_eq_u64 vcc, 0
s_cselect_b32 s28, 1, 0
v_mov_b32 v24, s28
ds_write_b32 v29, v24 offset:24832
L_nxt:
s_cmp_lg_u32 s3, 1
s_cbranch_scc1 L_npf
s_getpc_b64 s[46:47]
global_load_dwordx4 v[64:67], v2, s[46:47] offset:0
global_load_dwordx4 v[68:71], v2, s[46:47] offset:1024
global_load_dwordx4 v[72:75], v2, s[46:47] offset:2048
global_load_dwordx4 v[76:79], v2, s[46:47] offset:3072
s_add_u32 s46, s46, 4096
s_addc_u32 s47, s47, 0
s_mov_b64 exec, 0x7fffff
global_load_dwordx4 v[64:67], v2, s[46:47]
s_mov_b64 exec, -1
L_npf:
L_late:
s_waitcnt lgkmcnt(0)
s_barrier
ds_read_b128 v[24:27], v23 offset:24576
ds_read_b32 v10, v29 offset:24832
ds_read_b128 v[12:15], v22 offset:8192
ds_read_b128 v[16:19], v22 offset:10240
s_mov_b64 vcc, s[18:19]
s_waitcnt lgkmcnt(3)
v_max_f32 v8, v24, v26
s_nop 1
v_max_f32_dpp v8, v8, v8 quad_perm:[1,0,3,2] row_mask:0xf bank_mask:0xf
s_nop 1
v_max_f32_dpp v8, v8, v8 quad_perm:[2,3,0,1] row_mask:0xf bank_mask:0xf
v_and_b32 v8, s97, v8
v_sub_f32 v24, v24, v8
v_sub_f32 v26, v26, v8
v_exp_f32 v24, v24
v_exp_f32 v26, v26
v_mul_f32 v9, v24, v25
v_fmac_f32 v9, v26, v27
s_waitcnt lgkmcnt(0)
v_readfirstlane_b32 s96, v10
v_mul_f32 v12, v24, v12
v_mul_f32 v13, v24, v13
v_mul_f32 v14, v24, v14
v_mul_f32 v15, v24, v15
v_fmac_f32 v12, v26, v16
v_fmac_f32 v13, v26, v17
v_fmac_f32 v14, v26, v18
v_fmac_f32 v15, v26, v19
v_add_f32_dpp v12, v12, v12 quad_perm:[1,0,3,2] row_mask:0xf bank_mask:0xf
v_add_f32_dpp v13, v13, v13 quad_perm:[1,0,3,2] row_mask:0xf bank_mask:0xf
v_add_f32_dpp v14, v14, v14 quad_perm:[1,0,3,2] row_mask:0xf bank_mask:0xf
v_add_f32_dpp v15, v15, v15 quad_perm:[1,0,3,2] row_mask:0xf bank_mask:0xf
v_add_f32_dpp v9, v9, v9 quad_perm:[1,0,3,2] row_mask:0xf bank_mask:0xf
v_add_f32_dpp v12, v12, v12 quad_perm:[2,3,0,1] row_mask:0xf bank_mask:0xf
v_add_f32_dpp v13, v13, v13 quad_perm:[2,3,0,1] row_mask:0xf bank_mask:0xf
v_add_f32_dpp v14, v14, v14 quad_perm:[2,3,0,1] row_mask:0xf bank_mask:0xf
v_add_f32_dpp v15, v15, v15 quad_perm:[2,3,0,1] row_mask:0xf bank_mask:0xf
v_add_f32_dpp v9, v9, v9 quad_perm:[2,3,0,1] row_mask:0xf bank_mask:0xf
v_cndmask_b32 v12, v12, v8, vcc
v_cndmask_b32 v13, v13, v9, vcc
v_cndmask_b32 v14, v14, v8, vcc
v_cndmask_b32 v15, v15, v9, vcc
v_and_or_b32 v12, v12, s97, v127
v_and_or_b32 v13, v13, s97, v127
v_and_or_b32 v14, v14, s97, v127
v_and_or_b32 v15, v15, s97, v127
s_mov_b64 exec, s[12:13]
s_cmp_eq_u32 s96, 1
s_cbranch_scc1 L_mb_b
global_store_dwordx4 v112, v[12:15], s[4:5] sc1
s_branch L_mb_c
L_mb_b:
global_store_dwordx4 v112, v[12:15], s[4:5]
L_mb_c:
s_mov_b64 exec, -1
s_mov_b64 s[38:39], s[10:11]
s_barrier
s_cmp_eq_u32 s93, 1
s_cbranch_scc1 L_ffn
s_cmp_lt_u32 s85, 8
s_cbranch_scc1 L_fin
L_h1:
global_load_dwordx4 v[24:27], v113, s[6:7] sc1
global_load_dwordx4 v[20:23], v114, s[6:7] offset:64 sc1
s_waitcnt vmcnt(0)
v_xor_b32 v24, v24, v127
v_xor_b32 v25, v25, v127
v_xor_b32 v26, v26, v127
v_xor_b32 v27, v27, v127
v_xor_b32 v20, v20, v127
v_xor_b32 v21, v21, v127
v_xor_b32 v22, v22, v127
v_xor_b32 v23, v23, v127
v_or3_b32 v8, v24, v25, v26
v_or3_b32 v8, v8, v27, v20
v_or3_b32 v8, v8, v21, v22
v_or_b32 v8, v8, v23
v_and_b32 v8, 0xff, v8
v_cmp_ne_u32 vcc, 0, v8
s_cbranch_vccz L_h1ok
s_mov_b64 exec, vcc
s_add_u32 s98, s98, 1
s_cmp_ge_u32 s98, 262144
s_cbranch_scc1 L_h1ok
s_branch L_h1
L_h1ok:
s_mov_b64 exec, -1
v_max_f32_dpp v20, v20, v20 row_ror:1 row_mask:0xf bank_mask:0xf
s_nop 1
v_max_f32_dpp v20, v20, v20 row_ror:2 row_mask:0xf bank_mask:0xf
s_nop 1
v_max_f32_dpp v20, v20, v20 row_ror:4 row_mask:0xf bank_mask:0xf
s_nop 1
v_max_f32_dpp v20, v20, v20 row_ror:8 row_mask:0xf bank_mask:0xf
v_sub_f32 v20, v22, v20
v_exp_f32 v20, v20
s_nop 0
v_mul_f32 v23, v20, v23
v_mul_f32 v24, v20, v24
v_mul_f32 v25, v20, v25
v_mul_f32 v26, v20, v26
v_mul_f32 v27, v20, v27
v_add_f32_dpp v23, v23, v23 row_ror:1 row_mask:0xf bank_mask:0xf
v_add_f32_dpp v24, v24, v24 row_ror:1 row_mask:0xf bank_mask:0xf
v_add_f32_dpp v25, v25, v25 row_ror:1 row_mask:0xf bank_mask:0xf
v_add_f32_dpp v26, v26, v26 row_ror:1 row_mask:0xf bank_mask:0xf
v_add_f32_dpp v27, v27, v27 row_ror:1 row_mask:0xf bank_mask:0xf
v_add_f32_dpp v23, v23, v23 row_ror:2 row_mask:0xf bank_mask:0xf
v_add_f32_dpp v24, v24, v24 row_ror:2 row_mask:0xf bank_mask:0xf
v_add_f32_dpp v25, v25, v25 row_ror:2 row_mask:0xf bank_mask:0xf
v_add_f32_dpp v26, v26, v26 row_ror:2 row_mask:0xf bank_mask:0xf
v_add_f32_dpp v27, v27, v27 row_ror:2 row_mask:0xf bank_mask:0xf
v_add_f32_dpp v23, v23, v23 row_ror:4 row_mask:0xf bank_mask:0xf
v_add_f32_dpp v24, v24, v24 row_ror:4 row_mask:0xf bank_mask:0xf
v_add_f32_dpp v25, v25, v25 row_ror:4 row_mask:0xf bank_mask:0xf
v_add_f32_dpp v26, v26, v26 row_ror:4 row_mask:0xf bank_mask:0xf
v_add_f32_dpp v27, v27, v27 row_ror:4 row_mask:0xf bank_mask:0xf
v_add_f32_dpp v23, v23, v23 row_ror:8 row_mask:0xf bank_mask:0xf
v_add_f32_dpp v24, v24, v24 row_ror:8 row_mask:0xf bank_mask:0xf
v_add_f32_dpp v25, v25, v25 row_ror:8 row_mask:0xf bank_mask:0xf
v_add_f32_dpp v26, v26, v26 row_ror:8 row_mask:0xf bank_mask:0xf
v_add_f32_dpp v27, v27, v27 row_ror:8 row_mask:0xf bank_mask:0xf
v_rcp_f32 v23, v23
s_nop 0
v_mul_f32 v24, v24, v23
v_mul_f32 v25, v25, v23
v_mul_f32 v26, v26, v23
v_mul_f32 v27, v27, v23
v_cvt_pk_bf16_f32 v24, v24, v24
v_cvt_pk_bf16_f32 v25, v25, v25
v_cvt_pk_bf16_f32 v26, v26, v26
v_cvt_pk_bf16_f32 v27, v27, v27
v_and_b32 v64, v24, v104
v_and_b32 v65, v24, v105
v_and_b32 v66, v24, v106
v_and_b32 v67, v24, v107
v_and_b32 v68, v25, v104
v_and_b32 v69, v25, v105
v_and_b32 v70, v25, v106
v_and_b32 v71, v25, v107
v_and_b32 v72, v26, v104
v_and_b32 v73, v26, v105
v_and_b32 v74, v26, v106
v_and_b32 v75, v26, v107
v_and_b32 v76, v27, v104
v_and_b32 v77, v27, v105
v_and_b32 v78, v27, v106
v_and_b32 v79, v27, v107
v_mfma_f32_16x16x32_bf16 v[12:15], v[32:35], v[64:67], 0
v_mfma_f32_16x16x32_bf16 v[16:19], v[48:51], v[64:67], 0
v_mfma_f32_16x16x32_bf16 v[12:15], v[36:39], v[68:71], v[12:15]
v_mfma_f32_16x16x32_bf16 v[16:19], v[52:55], v[68:71], v[16:19]
v_mfma_f32_16x16x32_bf16 v[12:15], v[40:43], v[72:75], v[12:15]
v_mfma_f32_16x16x32_bf16 v[16:19], v[56:59], v[72:75], v[16:19]
v_mfma_f32_16x16x32_bf16 v[12:15], v[44:47], v[76:79], v[12:15]
v_mfma_f32_16x16x32_bf16 v[16:19], v[60:63], v[76:79], v[16:19]
s_mov_b64 exec, s[14:15]
s_nop 5
ds_write_b128 v115, v[12:15] offset:0
ds_write_b128 v115, v[16:19] offset:512
s_mov_b64 exec, -1
s_waitcnt lgkmcnt(0)
s_barrier
ds_read_b128 v[24:27], v31 offset:0
s_waitcnt lgkmcnt(0)
v_add_f32_dpp v24, v24, v24 quad_perm:[1,0,3,2] row_mask:0xf bank_mask:0xf
v_add_f32_dpp v25, v25, v25 quad_perm:[1,0,3,2] row_mask:0xf bank_mask:0xf
v_add_f32_dpp v26, v26, v26 quad_perm:[1,0,3,2] row_mask:0xf bank_mask:0xf
v_add_f32_dpp v27, v27, v27 quad_perm:[1,0,3,2] row_mask:0xf bank_mask:0xf
v_add_f32_dpp v24, v24, v24 quad_perm:[2,3,0,1] row_mask:0xf bank_mask:0xf
v_add_f32_dpp v25, v25, v25 quad_perm:[2,3,0,1] row_mask:0xf bank_mask:0xf
v_add_f32_dpp v26, v26, v26 quad_perm:[2,3,0,1] row_mask:0xf bank_mask:0xf
v_add_f32_dpp v27, v27, v27 quad_perm:[2,3,0,1] row_mask:0xf bank_mask:0xf
v_add_f32_dpp v24, v24, v24 row_half_mirror row_mask:0xf bank_mask:0xf
v_add_f32_dpp v25, v25, v25 row_half_mirror row_mask:0xf bank_mask:0xf
v_add_f32_dpp v26, v26, v26 row_half_mirror row_mask:0xf bank_mask:0xf
v_add_f32_dpp v27, v27, v27 row_half_mirror row_mask:0xf bank_mask:0xf
v_and_or_b32 v24, v24, s97, v127
v_and_or_b32 v25, v25, s97, v127
v_and_or_b32 v26, v26, s97, v127
v_and_or_b32 v27, v27, s97, v127
s_mov_b64 exec, s[16:17]
global_store_dwordx4 v30, v[24:27], s[8:9] sc1
s_mov_b64 exec, -1
s_sub_u32 s29, s3, 4
s_cmp_lt_u32 s29, 2
s_cbranch_scc0 L_role
s_lshr_b32 s28, s2, 7
s_lshl_b32 s28, s28, 4
s_add_u32 s28, s28, s29
s_sub_u32 s29, s85, 8
s_lshl_b32 s29, s29, 1
s_add_u32 s28, s28, s29
s_lshl_b32 s30, s28, 6
s_add_u32 s40, s76, s30
s_addc_u32 s41, s77, 0
v_and_b32 v21, 7, v0
v_lshlrev_b32 v22, 1, v21
global_load_ushort v108, v22, s[40:41] offset:0
global_load_ushort v109, v22, s[40:41] offset:16
global_load_ushort v110, v22, s[40:41] offset:32
global_load_ushort v111, v22, s[40:41] offset:48
s_lshl_b32 s30, s28, 7
s_add_u32 s42, s38, s30
s_addc_u32 s43, s39, 0
s_lshl_b32 s30, s28, 4
s_lshl_b32 s31, s99, 12
s_add_u32 s30, s30, s31
s_add_u32 s30, s30, 131072
s_add_u32 s44, s80, s30
s_addc_u32 s45, s81, 0
s_lshr_b32 s29, s28, 4
s_lshl_b32 s29, s29, 16
s_and_b32 s28, s28, 15
s_lshl_b32 s28, s28, 7
s_add_u32 s28, s28, s29
s_add_u32 s28, s28, 262144
s_add_u32 s48, s80, s28
s_addc_u32 s49, s81, 0
s_add_u32 s50, s48, 4096
s_addc_u32 s51, s49, 0
v_lshrrev_b32 v20, 3, v0
v_lshlrev_b32 v28, 13, v20
v_lshl_add_u32 v28, v21, 4, v28
v_lshlrev_b32 v11, 9, v0
L_h2a:
global_load_dwordx4 v[64:67], v28, s[48:49] offset:0 sc1
global_load_dwordx4 v[68:71], v28, s[48:49] offset:2048 sc1
global_load_dwordx4 v[72:75], v28, s[50:51] offset:0 sc1
global_load_dwordx4 v[76:79], v28, s[50:51] offset:2048 sc1
s_waitcnt vmcnt(0)
v_xor_b32 v64, v64, v127
v_xor_b32 v65, v65, v127
v_xor_b32 v66, v66, v127
v_xor_b32 v67, v67, v127
v_xor_b32 v68, v68, v127
v_xor_b32 v69, v69, v127
v_xor_b32 v70, v70, v127
v_xor_b32 v71, v71, v127
v_xor_b32 v72, v72, v127
v_xor_b32 v73, v73, v127
v_xor_b32 v74, v74, v127
v_xor_b32 v75, v75, v127
v_xor_b32 v76, v76, v127
v_xor_b32 v77, v77, v127
v_xor_b32 v78, v78, v127
v_xor_b32 v79, v79, v127
v_or3_b32 v20, v64, v65, v66
v_or3_b32 v20, v20, v67, v68
v_or3_b32 v20, v20, v69, v70
v_or3_b32 v20, v20, v71, v72
v_or3_b32 v20, v20, v73, v74
v_or3_b32 v20, v20, v75, v76
v_or3_b32 v20, v20, v77, v78
v_or_b32 v20, v20, v79
v_and_b32 v20, 0xff, v20
v_cmp_ne_u32 vcc, 0, v20
s_cbranch_vccz L_h2aok
s_mov_b64 exec, vcc
s_add_u32 s98, s98, 1
s_cmp_ge_u32 s98, 262144
s_cbranch_scc1 L_h2aok
s_branch L_h2a
L_h2aok:
s_mov_b64 exec, -1
v_add_f32 v24, v64, v68
v_add_f32 v25, v65, v69
v_add_f32 v26, v66, v70
v_add_f32 v27, v67, v71
v_add_f32 v20, v72, v76
v_add_f32 v21, v73, v77
v_add_f32 v22, v74, v78
v_add_f32 v23, v75, v79
v_add_f32 v24, v24, v20
v_add_f32 v25, v25, v21
v_add_f32 v26, v26, v22
v_add_f32 v27, v27, v23
v_add_f32_dpp v24, v24, v24 row_ror:8 row_mask:0xf bank_mask:0xf
v_add_f32_dpp v25, v25, v25 row_ror:8 row_mask:0xf bank_mask:0xf
v_add_f32_dpp v26, v26, v26 row_ror:8 row_mask:0xf bank_mask:0xf
v_add_f32_dpp v27, v27, v27 row_ror:8 row_mask:0xf bank_mask:0xf
v_mov_b32 v20, v24
v_mov_b32 v21, v25
v_mov_b32 v22, v26
v_mov_b32 v23, v27
v_permlane16_swap_b32 v24, v20
v_permlane16_swap_b32 v25, v21
v_permlane16_swap_b32 v26, v22
v_permlane16_swap_b32 v27, v23
v_add_f32 v24, v24, v20
v_add_f32 v25, v25, v21
v_add_f32 v26, v26, v22
v_add_f32 v27, v27, v23
v_mov_b32 v20, v24
v_mov_b32 v21, v25
v_mov_b32 v22, v26
v_mov_b32 v23, v27
v_permlane32_swap_b32 v24, v20
v_permlane32_swap_b32 v25, v21
v_permlane32_swap_b32 v26, v22
v_permlane32_swap_b32 v27, v23
v_add_f32 v24, v24, v20
v_add_f32 v25, v25, v21
v_add_f32 v26, v26, v22
v_add_f32 v27, v27, v23
v_cvt_pk_bf16_f32 v24, v24, v25
v_cvt_pk_bf16_f32 v26, v26, v27
v_and_b32 v25, s88, v24
v_and_b32 v27, s88, v26
v_lshlrev_b32 v24, 16, v24
v_lshlrev_b32 v26, 16, v26
v_lshlrev_b32 v20, 16, v108
v_lshlrev_b32 v21, 16, v109
v_lshlrev_b32 v22, 16, v110
v_lshlrev_b32 v23, 16, v111
v_add_f32 v24, v24, v20
v_add_f32 v25, v25, v21
v_add_f32 v26, v26, v22
v_add_f32 v27, v27, v23
v_cvt_pk_bf16_f32 v24, v24, v25
v_cvt_pk_bf16_f32 v26, v26, v27
v_and_b32 v25, s88, v24
v_and_b32 v27, s88, v26
v_lshlrev_b32 v24, 16, v24
v_lshlrev_b32 v26, 16, v26
v_or_b32 v12, v24, v127
v_or_b32 v13, v25, v127
v_or_b32 v14, v26, v127
v_or_b32 v15, v27, v127
s_mov_b64 exec, 0xff
s_cmp_eq_u32 s96, 1
s_cbranch_scc1 L_h_b
global_store_dwordx4 v2, v[12:15], s[42:43] sc1
s_branch L_h_c
L_h_b:
global_store_dwordx4 v2, v[12:15], s[42:43]
L_h_c:
s_mov_b64 exec, -1
v_add_f32 v20, v24, v25
v_add_f32 v21, v26, v27
v_add_f32 v20, v20, v21
s_nop 1
v_add_f32_dpp v20, v20, v20 quad_perm:[1,0,3,2] row_mask:0xf bank_mask:0xf
s_nop 1
v_add_f32_dpp v20, v20, v20 quad_perm:[2,3,0,1] row_mask:0xf bank_mask:0xf
s_nop 1
v_add_f32_dpp v20, v20, v20 row_half_mirror row_mask:0xf bank_mask:0xf
v_mul_f32 v20, 0x3d000000, v20
v_and_b32 v20, s97, v20
v_sub_f32 v24, v24, v20
v_sub_f32 v25, v25, v20
v_sub_f32 v26, v26, v20
v_sub_f32 v27, v27, v20
v_mul_f32 v21, v24, v24
v_fmac_f32 v21, v25, v25
v_fmac_f32 v21, v26, v26
v_fmac_f32 v21, v27, v27
s_nop 1
v_add_f32_dpp v21, v21, v21 quad_perm:[1,0,3,2] row_mask:0xf bank_mask:0xf
s_nop 1
v_add_f32_dpp v21, v21, v21 quad_perm:[2,3,0,1] row_mask:0xf bank_mask:0xf
s_nop 1
v_add_f32_dpp v21, v21, v21 row_half_mirror row_mask:0xf bank_mask:0xf
v_and_or_b32 v21, v21, s97, v127
v_or_b32 v20, v20, v127
v_mov_b32 v22, v20
v_mov_b32 v23, v21
s_mov_b64 exec, 0xff
s_cmp_eq_u32 s96, 1
s_cbranch_scc1 L_hs_b
global_store_dwordx4 v11, v[20:23], s[44:45] sc1
s_branch L_hs_c
L_hs_b:
global_store_dwordx4 v11, v[20:23], s[44:45]
L_hs_c:
s_mov_b64 exec, -1
L_role:
s_cmp_eq_u32 s93, 2
s_cbranch_scc1 L_down
s_branch L_fin
L_ffn:
global_load_dwordx4 v[80:83], v[48:49], off
v_add_co_u32 v48, vcc, 0x7000, v48
s_nop 1
v_addc_co_u32 v49, vcc, 0, v49, vcc
global_load_dwordx4 v[84:87], v[48:49], off
v_add_co_u32 v48, vcc, 0x7000, v48
s_nop 1
v_addc_co_u32 v49, vcc, 0, v49, vcc
global_load_dwordx4 v[88:91], v[48:49], off
v_add_co_u32 v48, vcc, 0x7000, v48
s_nop 1
v_addc_co_u32 v49, vcc, 0, v49, vcc
global_load_dwordx4 v[92:95], v[48:49], off
s_cmp_eq_u32 s93, 1
s_cbranch_scc0 L_nwd
s_cmp_lt_u32 s3, 4
s_cbranch_scc0 L_nwd
s_lshl_b32 s28, s92, 14
s_lshl_b32 s29, s3, 8
s_add_u32 s28, s28, s29
s_add_u32 s36, s100, s28
s_addc_u32 s37, s101, 0
v_lshrrev_b32 v24, 4, v0
v_lshlrev_b32 v24, 12, v24
v_and_b32 v25, 15, v0
v_lshl_add_u32 v24, v25, 4, v24
global_load_dwordx4 v[32:35], v24, s[36:37] offset:0 nt
global_load_dwordx4 v[36:39], v24, s[36:37] offset:1024 nt
global_load_dwordx4 v[40:43], v24, s[36:37] offset:2048 nt
global_load_dwordx4 v[44:47], v24, s[36:37] offset:3072 nt
L_nwd:
v_bfe_u32 v20, v0, 1, 1
v_lshrrev_b32 v21, 2, v0
v_lshl_add_u32 v22, s3, 4, v21
v_lshlrev_b32 v28, 4, v22
v_lshl_add_u32 v28, v20, 11, v28
v_lshlrev_b32 v29, 8, v20
v_lshl_add_u32 v29, v21, 4, v29
s_lshl_b32 s28, s99, 3
s_add_u32 s28, s28, s3
s_lshl_b32 s28, s28, 9
s_add_u32 s28, s28, 131072
s_add_u32 s40, s80, s28
s_addc_u32 s41, s81, 0
s_mul_i32 s28, s92, 4224
s_lshl_b32 s29, s3, 10
s_add_u32 s28, s28, s29
s_add_u32 s28, s28, 4194304
s_add_u32 s46, s80, s28
s_addc_u32 s47, s81, 0
s_lshl_b32 s28, s3, 6
v_lshl_add_u32 v10, v0, 2, s28
v_bfe_u32 v20, v0, 3, 1
v_lshlrev_b32 v11, 6, v20
v_lshrrev_b32 v20, 4, v0
v_lshl_add_u32 v11, v20, 4, v11
v_and_b32 v22, 3, v0
v_lshl_add_u32 v9, s3, 2, v20
v_lshlrev_b32 v30, 7, v9
v_lshl_add_u32 v30, v22, 5, v30
v_lshlrev_b32 v9, 5, v22
v_bfe_u32 v23, v0, 2, 1
v_lshl_add_u32 v9, v23, 4, v9
v_bfe_u32 v23, v0, 3, 2
v_lshl_add_u32 v9, v23, 2, v9
v_lshrrev_b32 v23, 5, v0
v_lshl_add_u32 v9, v23, 11, v9
s_lshl_b32 s28, s3, 12
v_add_u32 v9, s28, v9
L_h2:
global_load_dwordx4 v[24:27], v28, s[38:39] sc1
global_load_dwordx4 v[20:23], v29, s[40:41] sc1
s_waitcnt vmcnt(0)
v_xor_b32 v20, v20, v127
v_xor_b32 v21, v21, v127
v_xor_b32 v22, v22, v127
v_xor_b32 v23, v23, v127
v_xor_b32 v24, v24, v127
v_xor_b32 v25, v25, v127
v_xor_b32 v26, v26, v127
v_xor_b32 v27, v27, v127
v_or3_b32 v12, v20, v21, v22
v_or3_b32 v12, v12, v23, v24
v_or3_b32 v12, v12, v25, v26
v_or_b32 v12, v12, v27
v_and_b32 v12, 0xff, v12
v_cmp_ne_u32 vcc, 0, v12
s_cbranch_vccz L_h2ok
s_add_u32 s98, s98, 1
s_cmp_ge_u32 s98, 262144
s_cbranch_scc1 L_h2ok
s_branch L_h2
L_h2ok:
v_add_f32_dpp v20, v20, v20 row_ror:4 row_mask:0xf bank_mask:0xf
s_nop 1
v_add_f32_dpp v20, v20, v20 row_ror:8 row_mask:0xf bank_mask:0xf
v_mov_b32 v21, v20
s_nop 1
v_permlane16_swap_b32 v20, v21
v_add_f32 v20, v20, v21
v_mov_b32 v21, v20
s_nop 1
v_permlane32_swap_b32 v20, v21
v_add_f32 v20, v20, v21
v_mul_f32 v20, 0x3d800000, v20
v_sub_f32 v22, v22, v20
v_mul_f32 v22, v22, v22
v_fmac_f32 v23, 0x42000000, v22
s_nop 1
v_add_f32_dpp v23, v23, v23 row_ror:4 row_mask:0xf bank_mask:0xf
s_nop 1
v_add_f32_dpp v23, v23, v23 row_ror:8 row_mask:0xf bank_mask:0xf
v_mov_b32 v21, v23
s_nop 1
v_permlane16_swap_b32 v23, v21
v_add_f32 v23, v23, v21
v_mov_b32 v21, v23
s_nop 1
v_permlane32_swap_b32 v23, v21
v_add_f32 v23, v23, v21
v_mul_f32 v23, 0x3b000000, v23
v_cvt_pk_bf16_f32 v23, v20, v23
v_lshlrev_b32 v20, 16, v23
v_and_b32 v23, s88, v23
v_add_f32 v23, 0x3727c5ac, v23
v_cvt_pk_bf16_f32 v23, v23, v23
v_and_b32 v23, s88, v23
v_sqrt_f32 v22, v23
s_nop 0
v_cvt_pk_bf16_f32 v22, v22, v22
v_and_b32 v22, s88, v22
v_rcp_f32 v21, v22
v_sub_f32 v24, v24, v20
v_sub_f32 v25, v25, v20
v_sub_f32 v26, v26, v20
v_sub_f32 v27, v27, v20
v_cvt_pk_bf16_f32 v24, v24, v25
v_cvt_pk_bf16_f32 v26, v26, v27
v_and_b32 v25, s88, v24
v_and_b32 v27, s88, v26
v_lshlrev_b32 v24, 16, v24
v_lshlrev_b32 v26, 16, v26
v_mul_f32 v12, v24, v21
v_mul_f32 v13, v25, v21
v_mul_f32 v14, v26, v21
v_mul_f32 v15, v27, v21
v_fma_f32 v24, -v12, v22, v24
v_fma_f32 v25, -v13, v22, v25
v_fma_f32 v26, -v14, v22, v26
v_fma_f32 v27, -v15, v22, v27
v_fma_f32 v12, v24, v21, v12
v_fma_f32 v13, v25, v21, v13
v_fma_f32 v14, v26, v21, v14
v_fma_f32 v15, v27, v21, v15
v_cvt_pk_bf16_f32 v24, v12, v12
v_cvt_pk_bf16_f32 v25, v13, v13
v_cvt_pk_bf16_f32 v26, v14, v14
v_cvt_pk_bf16_f32 v27, v15, v15
v_and_b32_dpp v64, v24, v3 quad_perm:[0,0,0,0] row_mask:0xf bank_mask:0xf
v_and_b32_dpp v65, v24, v4 quad_perm:[0,0,0,0] row_mask:0xf bank_mask:0xf
v_and_b32_dpp v66, v25, v3 quad_perm:[0,0,0,0] row_mask:0xf bank_mask:0xf
v_and_b32_dpp v67, v25, v4 quad_perm:[0,0,0,0] row_mask:0xf bank_mask:0xf
v_and_b32_dpp v68, v26, v3 quad_perm:[0,0,0,0] row_mask:0xf bank_mask:0xf
v_and_b32_dpp v69, v26, v4 quad_perm:[0,0,0,0] row_mask:0xf bank_mask:0xf
v_and_b32_dpp v70, v27, v3 quad_perm:[0,0,0,0] row_mask:0xf bank_mask:0xf
v_and_b32_dpp v71, v27, v4 quad_perm:[0,0,0,0] row_mask:0xf bank_mask:0xf
v_mfma_f32_16x16x16_bf16 v[12:15], v[80:81], v[64:65], 0
v_mfma_f32_16x16x16_bf16 v[16:19], v[82:83], v[64:65], 0
v_mfma_f32_16x16x16_bf16 v[12:15], v[84:85], v[66:67], v[12:15]
v_mfma_f32_16x16x16_bf16 v[16:19], v[86:87], v[66:67], v[16:19]
v_mfma_f32_16x16x16_bf16 v[12:15], v[88:89], v[68:69], v[12:15]
v_mfma_f32_16x16x16_bf16 v[16:19], v[90:91], v[68:69], v[16:19]
v_mfma_f32_16x16x16_bf16 v[12:15], v[92:93], v[70:71], v[12:15]
v_mfma_f32_16x16x16_bf16 v[16:19], v[94:95], v[70:71], v[16:19]
v_and_b32_dpp v72, v24, v3 quad_perm:[2,2,2,2] row_mask:0xf bank_mask:0xf
v_and_b32_dpp v73, v24, v4 quad_perm:[2,2,2,2] row_mask:0xf bank_mask:0xf
v_and_b32_dpp v74, v25, v3 quad_perm:[2,2,2,2] row_mask:0xf bank_mask:0xf
v_and_b32_dpp v75, v25, v4 quad_perm:[2,2,2,2] row_mask:0xf bank_mask:0xf
v_and_b32_dpp v76, v26, v3 quad_perm:[2,2,2,2] row_mask:0xf bank_mask:0xf
v_and_b32_dpp v77, v26, v4 quad_perm:[2,2,2,2] row_mask:0xf bank_mask:0xf
v_and_b32_dpp v78, v27, v3 quad_perm:[2,2,2,2] row_mask:0xf bank_mask:0xf
v_and_b32_dpp v79, v27, v4 quad_perm:[2,2,2,2] row_mask:0xf bank_mask:0xf
v_mfma_f32_16x16x16_bf16 v[96:99], v[80:81], v[72:73], 0
v_mfma_f32_16x16x16_bf16 v[100:103], v[82:83], v[72:73], 0
v_mfma_f32_16x16x16_bf16 v[96:99], v[84:85], v[74:75], v[96:99]
v_mfma_f32_16x16x16_bf16 v[100:103], v[86:87], v[74:75], v[100:103]
v_mfma_f32_16x16x16_bf16 v[96:99], v[88:89], v[76:77], v[96:99]
v_mfma_f32_16x16x16_bf16 v[100:103], v[90:91], v[76:77], v[100:103]
v_mfma_f32_16x16x16_bf16 v[96:99], v[92:93], v[78:79], v[96:99]
v_mfma_f32_16x16x16_bf16 v[100:103], v[94:95], v[78:79], v[100:103]
s_mov_b64 exec, s[82:83]
ds_write_b128 v30, v[12:15] offset:0
ds_write_b128 v30, v[16:19] offset:16
s_nop 3
ds_write_b128 v30, v[96:99] offset:4096
ds_write_b128 v30, v[100:103] offset:4112
s_mov_b64 exec, -1
s_waitcnt lgkmcnt(0)
s_barrier
s_cmp_ge_u32 s3, 2
s_cbranch_scc1 L_noact
ds_read_b32 v64, v9 offset:0
ds_read_b32 v65, v9 offset:128
ds_read_b32 v66, v9 offset:256
ds_read_b32 v67, v9 offset:384
ds_read_b32 v68, v9 offset:512
ds_read_b32 v69, v9 offset:640
ds_read_b32 v70, v9 offset:768
ds_read_b32 v71, v9 offset:896
ds_read_b32 v72, v9 offset:1024
ds_read_b32 v73, v9 offset:1152
ds_read_b32 v74, v9 offset:1280
ds_read_b32 v75, v9 offset:1408
ds_read_b32 v76, v9 offset:1536
ds_read_b32 v77, v9 offset:1664
ds_read_b32 v78, v9 offset:1792
ds_read_b32 v79, v9 offset:1920
s_waitcnt lgkmcnt(8)
v_add_f32 v64, v64, v65
v_add_f32 v66, v66, v67
v_add_f32 v68, v68, v69
v_add_f32 v70, v70, v71
v_add_f32 v64, v64, v66
v_add_f32 v68, v68, v70
v_add_f32 v64, v64, v68
s_waitcnt lgkmcnt(0)
v_add_f32 v72, v72, v73
v_add_f32 v74, v74, v75
v_add_f32 v76, v76, v77
v_add_f32 v78, v78, v79
v_add_f32 v72, v72, v74
v_add_f32 v76, v76, v78
v_add_f32 v72, v72, v76
v_add_f32 v24, v64, v72
v_mov_b32 v64, v24
s_nop 1
v_permlane32_swap_b32 v24, v64
v_add_f32 v24, v24, v64
v_cvt_pk_bf16_f32 v24, v24, v24
v_and_b32 v24, s88, v24
v_mov_b32 v25, v24
s_nop 1
v_permlane16_swap_b32 v24, v25
v_mul_f32 v26, s87, v24
v_exp_f32 v26, -v26
s_nop 0
v_add_f32 v26, 1.0, v26
v_rcp_f32 v26, v26
s_nop 0
v_mul_f32 v24, v24, v26
v_cvt_pk_bf16_f32 v24, v24, v24
v_and_b32 v24, s88, v24
v_mul_f32 v24, v24, v25
v_cvt_pk_bf16_f32 v20, v24, v24
s_mov_b64 exec, 0xffff
ds_write_b32 v10, v20 offset:24960
s_mov_b64 exec, -1
s_waitcnt lgkmcnt(0)
L_noact:
s_barrier
s_cmp_ge_u32 s3, 4
s_cbranch_scc1 L_fin
ds_read_b128 v[24:27], v11 offset:24960
s_waitcnt lgkmcnt(0)
v_and_b32 v64, v24, v104
v_and_b32 v65, v24, v105
v_and_b32 v66, v24, v106
v_and_b32 v67, v24, v107
v_and_b32 v68, v25, v104
v_and_b32 v69, v25, v105
v_and_b32 v70, v25, v106
v_and_b32 v71, v25, v107
v_and_b32 v72, v26, v104
v_and_b32 v73, v26, v105
v_and_b32 v74, v26, v106
v_and_b32 v75, v26, v107
v_and_b32 v76, v27, v104
v_and_b32 v77, v27, v105
v_and_b32 v78, v27, v106
v_and_b32 v79, v27, v107
v_mfma_f32_16x16x32_bf16 v[12:15], v[32:35], v[64:67], 0
v_mfma_f32_16x16x32_bf16 v[12:15], v[36:39], v[68:71], v[12:15]
v_mfma_f32_16x16x32_bf16 v[12:15], v[40:43], v[72:75], v[12:15]
v_mfma_f32_16x16x32_bf16 v[12:15], v[44:47], v[76:79], v[12:15]
s_nop 7
v_and_or_b32 v12, v12, s97, v127
v_and_or_b32 v13, v13, s97, v127
v_and_or_b32 v14, v14, s97, v127
v_and_or_b32 v15, v15, s97, v127
global_store_dwordx4 v2, v[12:15], s[46:47] sc1
s_branch L_fin
L_down:
s_lshr_b32 s28, s94, 2
s_lshl_b32 s28, s28, 5
s_and_b32 s29, s94, 1
s_lshl_b32 s29, s29, 2
s_add_u32 s95, s28, s29
s_bfe_u32 s96, s94, 0x10001
s_lshl_b32 s28, s3, 6
v_lshl_add_u32 v29, v0, 4, s28
s_cmp_eq_u32 s3, 7
s_cbranch_scc1 L_w7
s_lshl_b32 s28, s94, 6
s_add_u32 s28, s28, 4194304
s_add_u32 s40, s80, s28
s_addc_u32 s41, s81, 0
v_lshrrev_b32 v20, 2, v0
v_lshl_add_u32 v20, s3, 4, v20
v_mul_u32_u24 v28, 4224, v20
v_and_b32 v20, 3, v0
v_lshl_add_u32 v28, v20, 4, v28
s_barrier
global_load_dwordx4 v[64:67], v28, s[40:41] sc1
L_h3:
s_waitcnt vmcnt(0)
v_xor_b32 v64, v64, v127
v_xor_b32 v65, v65, v127
v_xor_b32 v66, v66, v127
v_xor_b32 v67, v67, v127
v_or3_b32 v20, v64, v65, v66
v_or_b32 v20, v20, v67
v_and_b32 v20, 0xff, v20
v_cmp_ne_u32 vcc, 0, v20
s_cbranch_vccz L_h3_ok0
global_load_dwordx4 v[64:67], v28, s[40:41] sc1
s_add_u32 s98, s98, 1
s_cmp_ge_u32 s98, 262144
s_cbranch_scc1 L_h3_ok0
s_branch L_h3
L_h3_ok0:
v_mov_b32 v24, v64
v_mov_b32 v25, v65
v_mov_b32 v26, v66
v_mov_b32 v27, v67
L_h3_done:
v_add_f32_dpp v24, v24, v24 row_ror:4 row_mask:0xf bank_mask:0xf
v_add_f32_dpp v25, v25, v25 row_ror:4 row_mask:0xf bank_mask:0xf
v_add_f32_dpp v26, v26, v26 row_ror:4 row_mask:0xf bank_mask:0xf
v_add_f32_dpp v27, v27, v27 row_ror:4 row_mask:0xf bank_mask:0xf
v_add_f32_dpp v24, v24, v24 row_ror:8 row_mask:0xf bank_mask:0xf
v_add_f32_dpp v25, v25, v25 row_ror:8 row_mask:0xf bank_mask:0xf
v_add_f32_dpp v26, v26, v26 row_ror:8 row_mask:0xf bank_mask:0xf
v_add_f32_dpp v27, v27, v27 row_ror:8 row_mask:0xf bank_mask:0xf
v_mov_b32 v20, v24
v_mov_b32 v21, v25
v_mov_b32 v22, v26
v_mov_b32 v23, v27
v_permlane16_swap_b32 v24, v20
v_permlane16_swap_b32 v25, v21
v_permlane16_swap_b32 v26, v22
v_permlane16_swap_b32 v27, v23
v_add_f32 v24, v24, v20
v_add_f32 v25, v25, v21
v_add_f32 v26, v26, v22
v_add_f32 v27, v27, v23
v_mov_b32 v20, v24
v_mov_b32 v21, v25
v_mov_b32 v22, v26
v_mov_b32 v23, v27
v_permlane32_swap_b32 v24, v20
v_permlane32_swap_b32 v25, v21
v_permlane32_swap_b32 v26, v22
v_permlane32_swap_b32 v27, v23
v_add_f32 v24, v24, v20
v_add_f32 v25, v25, v21
v_add_f32 v26, v26, v22
v_add_f32 v27, v27, v23
s_branch L_dnw
L_w7:
s_lshl_b32 s28, s96, 11
s_lshr_b32 s29, s94, 2
s_lshl_b32 s29, s29, 7
s_add_u32 s28, s28, s29
s_and_b32 s29, s94, 1
s_lshl_b32 s29, s29, 6
s_add_u32 s28, s28, s29
s_add_u32 s40, s38, s28
s_addc_u32 s41, s39, 0
v_and_b32 v21, 3, v0
v_lshlrev_b32 v28, 4, v21
global_load_dwordx4 v[64:67], v28, s[40:41] sc1
L_h3b:
s_waitcnt vmcnt(0)
v_xor_b32 v64, v64, v127
v_xor_b32 v65, v65, v127
v_xor_b32 v66, v66, v127
v_xor_b32 v67, v67, v127
v_or3_b32 v20, v64, v65, v66
v_or_b32 v20, v20, v67
v_and_b32 v20, 0xff, v20
v_cmp_ne_u32 vcc, 0, v20
s_cbranch_vccz L_h3b_ok0
global_load_dwordx4 v[64:67], v28, s[40:41] sc1
s_add_u32 s98, s98, 1
s_cmp_ge_u32 s98, 262144
s_cbranch_scc1 L_h3b_ok0
s_branch L_h3b
L_h3b_ok0:
v_mov_b32 v24, v64
v_mov_b32 v25, v65
v_mov_b32 v26, v66
v_mov_b32 v27, v67
L_h3b_done:
s_barrier
L_dnw:
s_mov_b64 exec, 0xf
ds_write_b128 v29, v[24:27] offset:25088
s_mov_b64 exec, -1
v_lshlrev_b32 v21, 2, v0
v_and_b32 v20, 3, v0
v_lshlrev_b32 v20, 4, v20
v_bfe_u32 v22, v0, 2, 2
v_lshl_add_u32 v20, v22, 1, v20
s_lshl_b32 s28, s96, 10
s_lshl_b32 s29, s95, 1
s_add_u32 s28, s28, s29
s_add_u32 s36, s78, s28
s_addc_u32 s37, s79, 0
s_waitcnt lgkmcnt(0)
s_barrier
s_cmp_lg_u32 s3, 0
s_cbranch_scc1 L_fin
s_mov_b64 exec, 0xffff
ds_read_b32 v32, v21 offset:25088
ds_read_b32 v33, v21 offset:25152
ds_read_b32 v34, v21 offset:25216
ds_read_b32 v35, v21 offset:25280
ds_read_b32 v36, v21 offset:25344
ds_read_b32 v37, v21 offset:25408
ds_read_b32 v38, v21 offset:25472
ds_read_b32 v39, v21 offset:25536
s_waitcnt lgkmcnt(0)
v_add_f32 v24, v32, v33
v_add_f32 v25, v34, v35
v_add_f32 v26, v36, v37
v_add_f32 v24, v24, v25
v_add_f32 v26, v26, v38
v_add_f32 v24, v24, v26
v_cvt_pk_bf16_f32 v24, v24, v24
v_and_b32 v24, s88, v24
v_add_f32 v24, v24, v39
v_cvt_pk_bf16_f32 v24, v24, v24
global_store_short v20, v24, s[36:37]
s_cmp_lg_u32 s2, 64
s_cbranch_scc1 L_fin
s_mov_b64 exec, 1
v_mov_b32 v21, s89
v_mov_b32 v20, 0
global_store_dword v20, v21, s[80:81] offset:0
L_fin:
L_end:
s_endpgm
.section .rodata,"a"
.p2align 6
.amdhsa_kernel sequential_preLN__gqa_block_cached__swiglu_ffn__decode_kernel
  .amdhsa_next_free_vgpr 128
  .amdhsa_next_free_sgpr 102
  .amdhsa_accum_offset 128
  .amdhsa_group_segment_fixed_size 0
  .amdhsa_kernarg_size 96
  .amdhsa_user_sgpr_count 2
  .amdhsa_user_sgpr_kernarg_segment_ptr 1
  .amdhsa_system_sgpr_workgroup_id_x 1
.end_amdhsa_kernel
```
